```python
import torch

def _softmax(x, axis=-1):
    return torch.softmax(x, dim=axis)
def _gelu(x):
    return torch.nn.functional.gelu(x, approximate="tanh")
def _silu(x):
    return torch.nn.functional.silu(x)
def _sigmoid(x):
    return torch.sigmoid(x)
def _layernorm(x, axis=-1, eps=1e-5):
    m = x.mean(dim=axis, keepdim=True)
    v = x.var(dim=axis, keepdim=True, unbiased=False)
    return (x - m) / torch.sqrt(v + eps)
def _scatter_add(tgt, idx, src, axis=0):
    return tgt.clone().index_add_(axis, idx, src)
def _segment_sum(src, seg, n):
    out = torch.zeros((n,) + src.shape[1:], dtype=src.dtype)
    return out.index_add_(0, seg, src)
def _pad(x, pw):
    flat = tuple(v for pair in reversed(pw) for v in pair)
    return torch.nn.functional.pad(x, flat)

kernel_name = 'recurrent_scan__sliding_block_cached__mixer_channel_mlp__decode'

def setup_inputs():

    _w = (lambda a: (lambda t: t.to(torch.bfloat16) if t.is_floating_point() else t)(torch.as_tensor(a)))
    def _A_setup():
        B, Sq, D = 1, 1, 512
        Hq, Hkv, Sk, Dh = 32, 8, 65536, 128
        assert Hq % Hkv == 0, (Hq, Hkv)
        return {
            "x": _w((lambda *s: torch.randn(*s, dtype=torch.bfloat16) * 0.1)(B, Sq, D)),
            "k_cache": _w((lambda *s: torch.randn(*s, dtype=torch.bfloat16) * 0.8)(B, Hkv, Sk, Dh)),
            "v_cache": _w((lambda *s: torch.randn(*s, dtype=torch.bfloat16) * 3.2)(B, Hkv, Sk, Dh)),
            "wq": _w((lambda *s: torch.randn(*s, dtype=torch.bfloat16) * 0.8)(D, Hq * Dh) * (D ** -0.5)),
            "wo": _w((lambda *s: torch.randn(*s, dtype=torch.bfloat16) * 3.2)(Hq * Dh, D) * ((Hq * Dh) ** -0.5)),
        }
    _A_in = _A_setup()

    def _B_setup():
        B, S, D, F = 1, 1, 512, 1792
        return {
            "x": _w((lambda *s: torch.randn(*s, dtype=torch.bfloat16) * 0.1)(B, S, D)),
            "w1": _w((lambda *s: torch.randn(*s, dtype=torch.bfloat16) * 3.2)(D, F) * (D ** -0.5)),
            "b1": _w((lambda *s: torch.randn(*s, dtype=torch.bfloat16) * 3.2)(F)),
            "w2": _w((lambda *s: torch.randn(*s, dtype=torch.bfloat16) * 3.2)(F, D) * (F ** -0.5)),
            "b2": _w((lambda *s: torch.randn(*s, dtype=torch.bfloat16) * 3.2)(D)),
        }
    _B_in = _B_setup()

    return {
        "A_x": _A_in["x"],
        "A_k_cache": _A_in["k_cache"],
        "A_v_cache": _A_in["v_cache"],
        "A_wq": _A_in["wq"],
        "A_wo": _A_in["wo"],
        "B_x": _B_in["x"],
        "B_w1": _B_in["w1"],
        "B_b1": _B_in["b1"],
        "B_w2": _B_in["w2"],
        "B_b2": _B_in["b2"],
    }

def reference(A_x, A_k_cache, A_v_cache, A_wq, A_wo, B_x, B_w1, B_b1, B_w2, B_b2):
    def _A_ref(x, k_cache, v_cache, wq, wo):
        B, Sq, D = x.shape
        Hq, Dh = 32, 128
        Hkv, Sk = k_cache.shape[1], k_cache.shape[2]
        W = min(4096, max(256, Sk // 4))
        rep = Hq // Hkv
        q = (lambda x, *d: x.permute(*d))((x @ wq).reshape(B, Sq, Hq, Dh), 0, 2, 1, 3)
        k = (lambda x, n, axis: torch.repeat_interleave(x, n, dim=axis))(k_cache[:, :, Sk - W:, :], rep, axis=1)
        v = (lambda x, n, axis: torch.repeat_interleave(x, n, dim=axis))(v_cache[:, :, Sk - W:, :], rep, axis=1)
        scores = torch.einsum("bhqd,bhkd->bhqk", q, k) * (Dh ** -0.5)
        p = _softmax(scores, axis=-1)
        o = torch.einsum("bhqk,bhkd->bhqd", p, v)
        return (lambda x, *d: x.permute(*d))(o, 0, 2, 1, 3).reshape(B, Sq, Hq * Dh) @ wo

    def _B_ref(x, w1, b1, w2, b2):
        y = _layernorm(x, axis=-1)
        h = _gelu(torch.einsum("bsd,df->bsf", y, w1) + b1)
        return torch.einsum("bsf,fd->bsd", h, w2) + b2

    x = A_x
    xn = _layernorm(x, axis=-1)
    s = _A_ref(xn, A_k_cache, A_v_cache, A_wq, A_wo)
    g = _silu(_B_ref(xn, B_w1, B_b1, B_w2, B_b2))
    return x + s * g
```

```asm
; @launch grid=(256,1,1) block=(448,1,1) lds=143872
.amdgcn_target "amdgcn-amd-amdhsa--gfx950"
.text
.globl recurrent_scan__sliding_block_cached__mixer_channel_mlp__decode_kernel
.p2align 12
.type recurrent_scan__sliding_block_cached__mixer_channel_mlp__decode_kernel,@function
recurrent_scan__sliding_block_cached__mixer_channel_mlp__decode_kernel:
  s_cmp_ge_u32 s2, 256
  s_cbranch_scc1 L_end
  v_lshrrev_b32 v1, 6, v0
  v_and_b32 v0, 63, v0
  v_readfirstlane_b32 s3, v1
  v_mov_b32 v2, 0
  v_mov_b32 v3, 0
  s_cmp_eq_u32 s3, 6
  s_cbranch_scc0 L_nz
  v_lshlrev_b32 v1, 3, v0
  ds_write_b64 v1, v[2:3]
  s_waitcnt lgkmcnt(0)
L_nz:
  s_load_dwordx16 s[4:19], s[0:1], 0
  s_load_dwordx8 s[20:27], s[0:1], 64
  s_load_dwordx2 s[28:29], s[0:1], 96
  s_and_b32 s30, s2, 7
  s_lshr_b32 s31, s2, 3
  v_lshrrev_b32 v4, 4, v0
  v_and_b32 v5, 15, v0
  v_bfe_u32 v6, v0, 2, 2
  v_and_b32 v7, 3, v0
  s_and_b32 s46, s31, 15
  s_cmp_ge_u32 s31, 30
  s_cselect_b32 s38, 16, 0
  v_lshlrev_b32 v10, 4, v0
  s_and_b32 s32, s31, 1
  s_lshr_b32 s44, s46, 2
  s_and_b32 s33, s46, 3
  s_barrier
  s_cmp_eq_u32 s3, 0
  s_cbranch_scc1 L_L
  v_mov_b32 v11, 0xffff0000
  v_mov_b32 v36, 1
  s_getreg_b32 s41, hwreg(HW_REG_XCC_ID)
  s_and_b32 s41, s41, 7
  s_cmp_le_u32 s3, 2
  s_cbranch_scc1 L_MQ
  s_mov_b64 exec, 0
  s_cmp_eq_u32 s3, 3
  s_cbranch_scc1 L_tc0
  s_cmp_eq_u32 s3, 4
  s_cbranch_scc1 L_tc1
  s_cmp_eq_u32 s3, 5
  s_cbranch_scc1 L_tc2
  s_cmp_eq_u32 s3, 6
  s_cbranch_scc1 L_tc3
L_tret:
  s_mov_b64 exec, -1
  s_sub_u32 s39, s3, 3
  s_cmp_ge_u32 s31, 16
  s_cbranch_scc1 L_O
  s_branch L_C
L_L:
  s_setprio 3
  s_mov_b32 m0, 768
  v_lshlrev_b32 v13, 1, v4
  v_xor_b32 v13, v5, v13
  v_lshlrev_b32 v13, 4, v13
  v_lshlrev_b32 v14, 2, v0
  s_cmp_ge_u32 s31, 16
  s_cbranch_scc1 L_LB
  s_lshl_b32 s34, s30, 24
  s_lshl_b32 s40, s31, 11
  s_add_u32 s34, s34, s40
  s_add_u32 s34, s34, 15728640
  v_lshrrev_b32 v11, 5, v0
  v_xor_b32 v11, v5, v11
  v_lshlrev_b32 v11, 4, v11
  v_lshl_add_u32 v8, v4, 8, v11
  v_add_u32 v8, s34, v8
  s_movk_i32 s35, 1024
  s_movk_i32 s47, 31744
  s_waitcnt lgkmcnt(0)
  global_load_lds_dwordx4 v10, s[4:5]
  s_mov_b32 m0, 512
  v_mov_b32 v9, 1
  global_load_lds_dword v2, s[28:29] sc1
  s_mov_b32 m0, 6656
  s_mov_b32 s36, 18
L_seg1:
  global_load_lds_dwordx4 v8, s[6:7] nt
  s_addk_i32 m0, 1056
  v_add_u32 v8, s35, v8
  global_load_lds_dwordx4 v8, s[6:7] nt
  s_addk_i32 m0, 1056
  v_add_u32 v8, s47, v8
  s_sub_u32 s36, s36, 1
  s_cbranch_scc0 L_seg1
  s_mov_b32 s36, 12
L_seg2:
  s_waitcnt vmcnt(39)
  global_load_lds_dwordx4 v8, s[6:7] nt
  ds_write_b32 v14, v9
  v_add_u32 v9, 1, v9
  v_add_u32 v8, s35, v8
  s_addk_i32 m0, 1056
  s_waitcnt vmcnt(39)
  global_load_lds_dwordx4 v8, s[6:7] nt
  ds_write_b32 v14, v9
  v_add_u32 v9, 1, v9
  v_add_u32 v8, s47, v8
  s_addk_i32 m0, 1056
  s_sub_u32 s36, s36, 1
  s_cbranch_scc0 L_seg2
  v_lshl_add_u32 v8, v4, 8, v13
  v_add_u32 v8, s34, v8
  s_mov_b32 s36, 31
L_seg3:
  s_waitcnt vmcnt(39)
  global_load_lds_dwordx4 v8, s[8:9] nt
  ds_write_b32 v14, v9
  v_add_u32 v9, 1, v9
  v_add_u32 v8, s35, v8
  s_addk_i32 m0, 1024
  s_waitcnt vmcnt(39)
  global_load_lds_dwordx4 v8, s[8:9] nt
  ds_write_b32 v14, v9
  v_add_u32 v9, 1, v9
  v_add_u32 v8, s47, v8
  s_addk_i32 m0, 1152
  s_sub_u32 s36, s36, 1
  s_cbranch_scc0 L_seg3
  v_mov_b32 v9, 98
  s_waitcnt vmcnt(32)
  ds_write_b32 v14, v9
  v_mov_b32 v9, 114
  s_waitcnt vmcnt(16)
  ds_write_b32 v14, v9
  v_mov_b32 v9, 130
  s_waitcnt vmcnt(0)
  ds_write_b32 v14, v9
  s_endpgm
L_LB:
  v_lshl_add_u32 v8, v4, 13, v13
  s_lshl_b32 s34, s33, 20
  s_lshl_b32 s40, s30, 10
  s_add_u32 s34, s34, s40
  s_lshl_b32 s40, s44, 8
  s_add_u32 s34, s34, s40
  v_add_u32 v8, s34, v8
  s_mov_b32 s35, 0x8000
  s_waitcnt lgkmcnt(0)
  global_load_lds_dwordx4 v10, s[4:5]
  s_mov_b32 m0, 6656
  s_mov_b32 s36, 7
L_bur4:
  global_load_lds_dwordx4 v8, s[10:11] offset:0 nt
  v_add_u32 v8, 31744, v8
  global_load_lds_dwordx4 v8, s[10:11] offset:1024 nt
  v_add_u32 v8, 31616, v8
  global_load_lds_dwordx4 v8, s[10:11] offset:2176 nt
  v_add_u32 v8, 31744, v8
  global_load_lds_dwordx4 v8, s[10:11] offset:3200 nt
  s_addk_i32 m0, 4352
  v_add_u32 v8, 35968, v8
  s_sub_u32 s36, s36, 1
  s_cbranch_scc0 L_bur4
  s_mov_b32 m0, 512
  v_lshrrev_b32 v11, 5, v0
  global_load_lds_dword v2, s[28:29] sc1
  v_lshlrev_b32 v11, 1, v11
  v_xor_b32 v11, v7, v11
  v_lshlrev_b32 v11, 4, v11
  v_lshrrev_b32 v12, 2, v0
  v_lshrrev_b32 v15, 1, v12
  v_and_b32 v16, 1, v12
  v_lshl_add_u32 v15, v16, 4, v15
  v_lshl_add_u32 v15, v15, 10, v11
  s_xor_b32 s35, s46, 8
  s_mul_i32 s34, s30, 229376
  s_lshl_b32 s40, s35, 6
  s_add_u32 s34, s34, s40
  v_add_u32 v15, s34, v15
  v_mul_u32_u24 v8, 3584, v12
  v_add_u32 v8, v8, v11
  s_lshr_b32 s35, s46, 1
  s_mul_i32 s34, s32, 917504
  s_mul_i32 s40, s30, 448
  s_add_u32 s34, s34, s40
  s_lshl_b32 s40, s35, 6
  s_add_u32 s34, s34, s40
  v_add_u32 v8, s34, v8
  s_mov_b32 m0, 41472
  s_mov_b32 s35, 57344
  s_cmp_ge_u32 s31, 30
  s_cbranch_scc1 L_mk0
  s_mov_b32 s36, 2
L_seg5:
  global_load_lds_dwordx4 v8, s[16:17] nt
  s_addk_i32 m0, 1024
  v_add_u32 v8, s35, v8
  global_load_lds_dwordx4 v8, s[16:17] nt
  s_addk_i32 m0, 1024
  v_add_u32 v8, s35, v8
  s_sub_u32 s36, s36, 1
  s_cbranch_scc0 L_seg5
  v_mov_b32 v9, 1
  s_waitcnt vmcnt(39)
  ds_write_b32 v14, v9
  v_mov_b32 v9, 17
  s_waitcnt vmcnt(23)
  ds_write_b32 v14, v9
  v_mov_b32 v9, 34
  s_waitcnt vmcnt(6)
  ds_write_b32 v14, v9
  s_branch L_mk1
L_mk0:
L_tc0:
  s_cbranch_execz L_tc4
  v_mov_b32 v9, 1
  s_waitcnt vmcnt(33)
  ds_write_b32 v14, v9
  v_mov_b32 v9, 17
  s_waitcnt vmcnt(17)
  ds_write_b32 v14, v9
  v_mov_b32 v9, 34
  s_waitcnt vmcnt(0)
  ds_write_b32 v14, v9
L_mk1:
  s_branch L_lw7
L_lw6:
  s_sleep 1
L_lw7:
  ds_read_b32 v37, v2 offset:280
  s_waitcnt lgkmcnt(0)
  v_cmp_gt_i32 vcc, 2, v37
  s_cbranch_vccnz L_lw6
  s_cmp_ge_u32 s31, 30
  s_cbranch_scc1 L_ld_w2
  s_mov_b32 s36, 4
L_seg8:
  global_load_lds_dwordx4 v8, s[16:17] nt
  s_addk_i32 m0, 1024
  v_add_u32 v8, s35, v8
  global_load_lds_dwordx4 v8, s[16:17] nt
  s_addk_i32 m0, 1024
  v_add_u32 v8, s35, v8
  s_sub_u32 s36, s36, 1
  s_cbranch_scc0 L_seg8
L_ld_w2:
  v_mov_b32 v8, v15
  s_mov_b32 m0, 57856
  v_mov_b32 v9, 15
  s_mov_b32 s36, 6
L_seg9:
  s_waitcnt vmcnt(35)
  global_load_lds_dwordx4 v8, s[20:21] nt
  ds_max_i32 v14, v9
  v_add_u32 v9, 1, v9
  v_add_u32 v8, 8192, v8
  s_addk_i32 m0, 1024
  s_waitcnt vmcnt(35)
  global_load_lds_dwordx4 v8, s[20:21] nt
  ds_max_i32 v14, v9
  v_add_u32 v9, 1, v9
  v_add_u32 v8, 24576, v8
  s_addk_i32 m0, 1024
  s_sub_u32 s36, s36, 1
  s_cbranch_scc0 L_seg9
  v_lshrrev_b32 v8, 1, v4
  v_and_b32 v12, 1, v4
  v_lshl_add_u32 v8, v12, 4, v8
  v_lshl_add_u32 v8, v8, 10, v13
  s_and_b32 s32, s46, 3
  s_lshr_b32 s33, s46, 2
  s_lshl_b32 s34, s30, 19
  s_lshl_b32 s40, s33, 17
  s_add_u32 s34, s34, s40
  s_lshl_b32 s40, s32, 8
  s_add_u32 s34, s34, s40
  v_add_u32 v8, s34, v8
  s_mov_b32 s35, 3
L_wo0:
  s_mov_b32 s36, 3
L_seg10:
  s_waitcnt vmcnt(35)
  global_load_lds_dwordx4 v8, s[12:13] nt
  ds_max_i32 v14, v9
  v_add_u32 v9, 1, v9
  v_add_u32 v8, 2048, v8
  s_addk_i32 m0, 1024
  s_waitcnt vmcnt(35)
  global_load_lds_dwordx4 v8, s[12:13] nt
  ds_max_i32 v14, v9
  v_add_u32 v9, 1, v9
  v_add_u32 v8, 2048, v8
  s_addk_i32 m0, 1152
  s_sub_u32 s36, s36, 1
  s_cbranch_scc0 L_seg10
  v_add_u32 v8, 16384, v8
  s_sub_u32 s35, s35, 1
  s_cbranch_scc0 L_wo0
  v_mov_b32 v9, 64
  s_waitcnt vmcnt(32)
  ds_write_b32 v14, v9
  v_mov_b32 v9, 72
  s_waitcnt vmcnt(24)
  ds_write_b32 v14, v9
  v_mov_b32 v9, 74
  s_waitcnt vmcnt(22)
  ds_write_b32 v14, v9
  v_mov_b32 v9, 88
  s_waitcnt vmcnt(8)
  ds_write_b32 v14, v9
  v_mov_b32 v9, 96
  s_waitcnt vmcnt(0)
  ds_write_b32 v14, v9
  s_endpgm
L_MQ:
  s_cmp_ge_u32 s31, 16
  s_cbranch_scc1 L_MQ2
  s_cmp_eq_u32 s3, 2
  s_cbranch_scc1 L_end
  s_cmp_lt_u32 s31, 12
  s_cbranch_scc1 L_end
  s_branch L_F
L_MQ2:
  s_mov_b32 s42, 0
  s_sub_u32 s39, s3, 1
  v_mul_u32_u24 v16, 2176, v4
  v_lshl_add_u32 v16, v6, 8, v16
  v_lshl_add_u32 v16, v7, 3, v16
  v_lshl_add_u32 v16, v6, 5, v16
  s_lshl_b32 s34, s39, 7
  v_add_u32 v16, s34, v16
  v_xor_b32 v17, 32, v16
  v_xor_b32 v22, 64, v16
  v_xor_b32 v23, 0x60, v16
  v_lshlrev_b32 v18, 4, v4
  s_lshl_b32 s34, s33, 8
  v_add_u32 v19, s34, v18
  s_lshl_b32 s34, s44, 11
  s_lshl_b32 s40, s30, 13
  s_add_u32 s34, s34, s40
  s_lshl_b32 s40, s33, 9
  s_add_u32 s34, s34, s40
  s_lshl_b32 s40, s39, 8
  s_add_u32 s34, s34, s40
  s_add_u32 s34, s34, 4096
  v_add_u32 v20, s34, v10
  v_add_u32 v21, 589824, v20
  v_mov_b32 v24, 0xff
  s_branch L_lw12
L_lw11:
  s_sleep 1
L_lw12:
  ds_read_b32 v37, v2 offset:0
  ds_read_b128 v[12:15], v10 offset:768
  s_waitcnt lgkmcnt(0)
  v_cmp_gt_i32 vcc, 1, v37
  s_cbranch_vccnz L_lw11
L_LN:
  v_lshlrev_b32 v40, 16, v12
  v_and_b32 v41, v11, v12
  v_lshlrev_b32 v42, 16, v13
  v_and_b32 v43, v11, v13
  v_lshlrev_b32 v44, 16, v14
  v_and_b32 v45, v11, v14
  v_lshlrev_b32 v46, 16, v15
  v_and_b32 v47, v11, v15
  v_add_f32 v48, v40, v41
  v_add_f32 v49, v42, v43
  v_add_f32 v50, v44, v45
  v_add_f32 v51, v46, v47
  v_add_f32 v48, v48, v49
  v_add_f32 v50, v50, v51
  v_add_f32 v48, v48, v50
  s_nop 1
  v_add_f32_dpp v48, v48, v48 quad_perm:[1,0,3,2] row_mask:0xf bank_mask:0xf
  s_nop 1
  v_add_f32_dpp v48, v48, v48 quad_perm:[2,3,0,1] row_mask:0xf bank_mask:0xf
  s_nop 1
  v_add_f32_dpp v48, v48, v48 row_half_mirror row_mask:0xf bank_mask:0xf
  s_nop 1
  v_add_f32_dpp v48, v48, v48 row_mirror row_mask:0xf bank_mask:0xf
  s_nop 1
  v_add_f32_dpp v48, v48, v48 row_bcast:15 row_mask:0xa bank_mask:0xf
  s_nop 1
  v_add_f32_dpp v48, v48, v48 row_bcast:31 row_mask:0xc bank_mask:0xf
  v_mov_b32 v49, 0x3b000000
  v_readlane_b32 s40, v48, 63
  s_nop 1
  v_mul_f32 v48, s40, v49
  v_sub_f32 v52, v40, v48
  v_sub_f32 v53, v41, v48
  v_sub_f32 v54, v42, v48
  v_sub_f32 v55, v43, v48
  v_sub_f32 v56, v44, v48
  v_sub_f32 v57, v45, v48
  v_sub_f32 v58, v46, v48
  v_sub_f32 v59, v47, v48
  v_mul_f32 v50, v52, v52
  v_mul_f32 v51, v53, v53
  v_fmac_f32 v50, v54, v54
  v_fmac_f32 v51, v55, v55
  v_fmac_f32 v50, v56, v56
  v_fmac_f32 v51, v57, v57
  v_fmac_f32 v50, v58, v58
  v_fmac_f32 v51, v59, v59
  v_add_f32 v50, v50, v51
  v_cvt_pk_bf16_f32 v48, v48, v48
  v_lshlrev_b32 v48, 16, v48
  v_add_f32_dpp v50, v50, v50 quad_perm:[1,0,3,2] row_mask:0xf bank_mask:0xf
  v_sub_f32 v40, v40, v48
  v_sub_f32 v41, v41, v48
  v_add_f32_dpp v50, v50, v50 quad_perm:[2,3,0,1] row_mask:0xf bank_mask:0xf
  v_sub_f32 v42, v42, v48
  v_sub_f32 v43, v43, v48
  v_add_f32_dpp v50, v50, v50 row_half_mirror row_mask:0xf bank_mask:0xf
  v_sub_f32 v44, v44, v48
  v_sub_f32 v45, v45, v48
  v_add_f32_dpp v50, v50, v50 row_mirror row_mask:0xf bank_mask:0xf
  v_sub_f32 v46, v46, v48
  v_sub_f32 v47, v47, v48
  v_add_f32_dpp v50, v50, v50 row_bcast:15 row_mask:0xa bank_mask:0xf
  v_cvt_pk_bf16_f32 v12, v40, v41
  v_cvt_pk_bf16_f32 v13, v42, v43
  v_add_f32_dpp v50, v50, v50 row_bcast:31 row_mask:0xc bank_mask:0xf
  v_cvt_pk_bf16_f32 v14, v44, v45
L_tc1:
  s_cbranch_execz L_tc5
  v_cvt_pk_bf16_f32 v15, v46, v47
  v_readlane_b32 s40, v50, 63
  v_lshlrev_b32 v40, 16, v12
  v_and_b32 v41, v11, v12
  v_mul_f32 v50, s40, v49
  v_cvt_pk_bf16_f32 v50, v50, v50
  v_lshlrev_b32 v50, 16, v50
  v_add_f32 v50, 0x3727c5ac, v50
  v_cvt_pk_bf16_f32 v50, v50, v50
  v_lshlrev_b32 v50, 16, v50
  v_sqrt_f32 v50, v50
  v_lshlrev_b32 v42, 16, v13
  v_and_b32 v43, v11, v13
  v_cvt_pk_bf16_f32 v50, v50, v50
  v_lshlrev_b32 v50, 16, v50
  v_rcp_f32 v50, v50
  v_lshlrev_b32 v44, 16, v14
  v_and_b32 v45, v11, v14
  v_lshlrev_b32 v46, 16, v15
  v_and_b32 v47, v11, v15
  v_mul_f32 v40, v40, v50
  v_mul_f32 v41, v41, v50
  v_mul_f32 v42, v42, v50
  v_mul_f32 v43, v43, v50
  v_mul_f32 v44, v44, v50
  v_mul_f32 v45, v45, v50
  v_mul_f32 v46, v46, v50
  v_mul_f32 v47, v47, v50
  v_cvt_pk_bf16_f32 v12, v40, v41
  v_cvt_pk_bf16_f32 v13, v42, v43
  v_cvt_pk_bf16_f32 v14, v44, v45
  v_cvt_pk_bf16_f32 v15, v46, v47
  s_cmp_eq_u32 s42, 0
  s_cbranch_scc0 L_M
  ds_write_b128 v10, v[12:15] offset:1792
  ds_read_b128 v[96:99], v19 offset:1792
  ds_read_b128 v[100:103], v19 offset:1856
  ds_read_b128 v[104:107], v19 offset:1920
  ds_read_b128 v[108:111], v19 offset:1984
  s_branch L_lw14
L_lw13:
  s_sleep 1
L_lw14:
  ds_read_b32 v37, v2 offset:0
  s_waitcnt lgkmcnt(0)
  v_cmp_gt_i32 vcc, 17, v37
  s_cbranch_vccnz L_lw13
  ds_read_b64_tr_b16 v[56:57], v16 offset:6656
  ds_read_b64_tr_b16 v[58:59], v16 offset:7680
  ds_read_b64_tr_b16 v[60:61], v17 offset:6656
  ds_read_b64_tr_b16 v[62:63], v17 offset:7680
  ds_read_b64_tr_b16 v[64:65], v22 offset:6656
  ds_read_b64_tr_b16 v[66:67], v22 offset:7680
  ds_read_b64_tr_b16 v[68:69], v23 offset:6656
  ds_read_b64_tr_b16 v[70:71], v23 offset:7680
  ds_read_b64_tr_b16 v[72:73], v16 offset:15360
  ds_read_b64_tr_b16 v[74:75], v16 offset:16384
  ds_read_b64_tr_b16 v[76:77], v17 offset:15360
  ds_read_b64_tr_b16 v[78:79], v17 offset:16384
  ds_read_b64_tr_b16 v[80:81], v22 offset:15360
  ds_read_b64_tr_b16 v[82:83], v22 offset:16384
  ds_read_b64_tr_b16 v[84:85], v23 offset:15360
  ds_read_b64_tr_b16 v[86:87], v23 offset:16384
  s_waitcnt lgkmcnt(0)
  v_mfma_f32_16x16x32_bf16 v[112:115], v[96:99], v[56:59], 0
  v_mfma_f32_16x16x32_bf16 v[116:119], v[96:99], v[60:63], 0
  v_mfma_f32_16x16x32_bf16 v[120:123], v[96:99], v[64:67], 0
  v_mfma_f32_16x16x32_bf16 v[124:127], v[96:99], v[68:71], 0
  v_mfma_f32_16x16x32_bf16 v[112:115], v[100:103], v[72:75], v[112:115]
  v_mfma_f32_16x16x32_bf16 v[116:119], v[100:103], v[76:79], v[116:119]
  v_mfma_f32_16x16x32_bf16 v[120:123], v[100:103], v[80:83], v[120:123]
  v_mfma_f32_16x16x32_bf16 v[124:127], v[100:103], v[84:87], v[124:127]
  s_branch L_lw16
L_lw15:
  s_sleep 1
L_lw16:
  ds_read_b32 v37, v2 offset:0
  s_waitcnt lgkmcnt(0)
  v_cmp_gt_i32 vcc, 34, v37
  s_cbranch_vccnz L_lw15
  ds_read_b64_tr_b16 v[56:57], v16 offset:24064
  ds_read_b64_tr_b16 v[58:59], v16 offset:25088
  ds_read_b64_tr_b16 v[60:61], v17 offset:24064
  ds_read_b64_tr_b16 v[62:63], v17 offset:25088
  ds_read_b64_tr_b16 v[64:65], v22 offset:24064
  ds_read_b64_tr_b16 v[66:67], v22 offset:25088
  ds_read_b64_tr_b16 v[68:69], v23 offset:24064
  ds_read_b64_tr_b16 v[70:71], v23 offset:25088
  ds_read_b64_tr_b16 v[72:73], v16 offset:32768
  ds_read_b64_tr_b16 v[74:75], v16 offset:33792
  ds_read_b64_tr_b16 v[76:77], v17 offset:32768
  ds_read_b64_tr_b16 v[78:79], v17 offset:33792
  ds_read_b64_tr_b16 v[80:81], v22 offset:32768
  ds_read_b64_tr_b16 v[82:83], v22 offset:33792
  ds_read_b64_tr_b16 v[84:85], v23 offset:32768
  ds_read_b64_tr_b16 v[86:87], v23 offset:33792
  ds_read_b32 v9, v2 offset:512
  s_waitcnt lgkmcnt(0)
  v_mfma_f32_16x16x32_bf16 v[112:115], v[104:107], v[56:59], v[112:115]
  v_mfma_f32_16x16x32_bf16 v[116:119], v[104:107], v[60:63], v[116:119]
  v_mfma_f32_16x16x32_bf16 v[120:123], v[104:107], v[64:67], v[120:123]
  v_mfma_f32_16x16x32_bf16 v[124:127], v[104:107], v[68:71], v[124:127]
  v_mfma_f32_16x16x32_bf16 v[112:115], v[108:111], v[72:75], v[112:115]
  v_mfma_f32_16x16x32_bf16 v[116:119], v[108:111], v[76:79], v[116:119]
  v_mfma_f32_16x16x32_bf16 v[120:123], v[108:111], v[80:83], v[120:123]
  v_mfma_f32_16x16x32_bf16 v[124:127], v[108:111], v[84:87], v[124:127]
  s_mov_b32 s40, 0x9E3779B1
  v_mul_lo_u32 v8, v9, s40
  v_add_u32 v8, 0x7F4A7C15, v8
  v_or_b32 v8, 0x80000000, v8
  v_xor_b32 v38, s41, v8
  v_lshrrev_b32 v89, 8, v38
  v_lshrrev_b32 v90, 16, v38
  v_lshrrev_b32 v91, 24, v38
  s_mov_b64 exec, 0xffff
  v_bfi_b32 v88, v24, v38, v112
  v_bfi_b32 v89, v24, v89, v116
  v_bfi_b32 v90, v24, v90, v120
  v_bfi_b32 v91, v24, v91, v124
  global_store_dwordx4 v20, v[88:91], s[28:29]
  s_mov_b64 exec, 1
  ds_add_u32 v2, v36 offset:280
  s_mov_b64 exec, 0xffff
  global_store_dwordx4 v21, v[88:91], s[28:29] sc1
  s_cmp_eq_u32 s3, 2
  s_cbranch_scc1 L_W
  s_mov_b64 exec, -1
  s_mov_b32 s42, 1
  s_branch L_LN
L_W:
  s_lshr_b32 s34, s46, 2
  s_lshl_b32 s34, s34, 8
  s_lshl_b32 s40, s30, 10
  s_add_u32 s34, s34, s40
  s_add_u32 s34, s34, 163840
  v_add_u32 v18, s34, v10
  s_mov_b32 m0, 4864
  v_mov_b32 v40, 0
  v_mov_b32 v41, 0
  v_mov_b32 v42, 0
  v_mov_b32 v43, 0
  ds_write_b128 v10, v[40:43] offset:4864
  v_and_b32 v17, 7, v0
  v_lshrrev_b32 v16, 3, v0
  v_lshl_add_u32 v17, v17, 1, v16
  v_lshlrev_b32 v17, 2, v17
  s_branch L_lw18
L_lw17:
  s_sleep 2
L_lw18:
  ds_read_b32 v37, v2 offset:0
  s_waitcnt lgkmcnt(0)
  v_cmp_gt_i32 vcc, 72, v37
  s_cbranch_vccnz L_lw17
  s_mov_b32 s36, 262144
L_ml:
  global_load_lds_dwordx4 v18, s[28:29] sc1
  s_sub_u32 s36, s36, 1
  s_cbranch_scc1 L_mlx
  ds_read_b128 v[40:43], v10 offset:4864
  s_waitcnt lgkmcnt(0)
  v_xor_b32 v44, v41, v8
  v_bitop3_b32 v44, v44, v43, v8 bitop3:0xf6
  v_cmp_ne_u32 vcc, 0, v44
  s_cbranch_vccz L_mlx
  ds_read_b128 v[40:43], v10 offset:4864
  s_waitcnt lgkmcnt(0)
  v_xor_b32 v44, v41, v8
  v_bitop3_b32 v44, v44, v43, v8 bitop3:0xf6
  v_cmp_ne_u32 vcc, 0, v44
  s_cbranch_vccz L_mlx
L_tc2:
  s_cbranch_execz L_tc6
  ds_read_b128 v[40:43], v10 offset:4864
  s_waitcnt lgkmcnt(0)
  v_xor_b32 v44, v41, v8
  v_bitop3_b32 v44, v44, v43, v8 bitop3:0xf6
  v_cmp_ne_u32 vcc, 0, v44
  s_cbranch_vccnz L_ml
L_mlx:
  v_mov_b32 v44, v40
  s_nop 1
  v_max_f32_dpp v44, v44, v44 quad_perm:[1,0,3,2] row_mask:0xf bank_mask:0xf
  s_nop 1
  v_max_f32_dpp v44, v44, v44 quad_perm:[2,3,0,1] row_mask:0xf bank_mask:0xf
  s_nop 1
  v_max_f32_dpp v44, v44, v44 row_half_mirror row_mask:0xf bank_mask:0xf
  s_nop 1
  v_max_f32_dpp v44, v44, v44 row_mirror row_mask:0xf bank_mask:0xf
  v_sub_f32 v40, v40, v44
  v_exp_f32 v40, v40
  s_nop 0
  v_mul_f32 v44, v40, v42
  s_nop 1
  v_add_f32_dpp v44, v44, v44 quad_perm:[1,0,3,2] row_mask:0xf bank_mask:0xf
  s_nop 1
  v_add_f32_dpp v44, v44, v44 quad_perm:[2,3,0,1] row_mask:0xf bank_mask:0xf
  s_nop 1
  v_add_f32_dpp v44, v44, v44 row_half_mirror row_mask:0xf bank_mask:0xf
  s_nop 1
  v_add_f32_dpp v44, v44, v44 row_mirror row_mask:0xf bank_mask:0xf
  v_rcp_f32 v44, v44
  s_nop 0
  v_mul_f32 v40, v40, v44
  ds_write_b32 v17, v40 offset:4608
  s_mov_b64 exec, 1
  ds_add_u32 v2, v36 offset:268
  s_mov_b64 exec, -1
  s_waitcnt vmcnt(0)
  s_endpgm
L_M:
  ds_write_b128 v10, v[12:15] offset:2816
  s_lshl_b32 s34, s32, 9
  v_add_u32 v19, s34, v18
  v_lshlrev_b32 v16, 9, v4
  v_lshl_add_u32 v16, v6, 6, v16
  v_lshl_add_u32 v16, v7, 3, v16
  v_and_b32 v17, 1, v4
  v_lshl_add_u32 v16, v17, 5, v16
  v_add_u32 v16, 41472, v16
  v_xor_b32 v17, 32, v16
  ds_read_b128 v[96:99], v19 offset:2816
  ds_read_b128 v[100:103], v19 offset:2880
  ds_read_b128 v[104:107], v19 offset:2944
  ds_read_b128 v[108:111], v19 offset:3008
  ds_read_b128 v[112:115], v19 offset:3072
  ds_read_b128 v[116:119], v19 offset:3136
  ds_read_b128 v[120:123], v19 offset:3200
  ds_read_b128 v[124:127], v19 offset:3264
  v_min_u32 v24, 47, v0
  v_add_u32 v24, 64, v24
  s_mul_i32 s34, s30, 448
  v_lshl_add_u32 v20, v4, 5, v5
  v_lshl_add_u32 v20, v20, 1, s34
  global_load_ushort v22, v20, s[18:19]
  global_load_ushort v23, v20, s[18:19] offset:32
  v_lshrrev_b32 v25, 4, v24
  v_and_b32 v26, 15, v24
  v_lshl_add_u32 v20, v25, 5, v26
  v_lshl_add_u32 v20, v20, 1, s34
  global_load_ushort v30, v20, s[18:19]
  global_load_ushort v31, v20, s[18:19] offset:32
  s_lshl_b32 s34, s30, 12
  s_add_u32 s34, s34, 98304
  v_add_u32 v21, s34, v10
  v_lshl_add_u32 v32, v24, 4, s34
  v_lshlrev_b32 v33, 2, v24
  s_lshr_b32 s35, s46, 1
  s_mul_i32 s33, s32, 1792
  s_lshl_b32 s40, s35, 8
  s_add_u32 s33, s33, s40
  v_add_u32 v20, s33, v21
  v_add_u32 v29, 589824, v20
  s_xor_b32 s35, s46, 8
  s_lshl_b32 s34, s35, 11
  s_lshl_b32 s40, s30, 7
  s_add_u32 s34, s34, s40
  s_add_u32 s34, s34, 262144
  v_lshrrev_b32 v28, 3, v5
  v_lshlrev_b32 v28, 10, v28
  v_and_b32 v34, 7, v0
  v_lshl_add_u32 v28, v34, 4, v28
  v_add_u32 v28, s34, v28
  s_cmp_ge_u32 s31, 30
  s_cbranch_scc1 L_M_h
  s_branch L_lw20
L_lw19:
  s_sleep 1
L_lw20:
  ds_read_b32 v37, v2 offset:0
  s_waitcnt lgkmcnt(0)
  v_cmp_gt_i32 vcc, 42, v37
  s_cbranch_vccnz L_lw19
  ds_read_b64_tr_b16 v[56:57], v16 offset:0
  ds_read_b64_tr_b16 v[58:59], v16 offset:256
  ds_read_b64_tr_b16 v[60:61], v17 offset:0
  ds_read_b64_tr_b16 v[62:63], v17 offset:256
  ds_read_b64_tr_b16 v[64:65], v16 offset:2048
  ds_read_b64_tr_b16 v[66:67], v16 offset:2304
  ds_read_b64_tr_b16 v[68:69], v17 offset:2048
  ds_read_b64_tr_b16 v[70:71], v17 offset:2304
  ds_read_b64_tr_b16 v[72:73], v16 offset:4096
  ds_read_b64_tr_b16 v[74:75], v16 offset:4352
  ds_read_b64_tr_b16 v[76:77], v17 offset:4096
  ds_read_b64_tr_b16 v[78:79], v17 offset:4352
  ds_read_b64_tr_b16 v[80:81], v16 offset:6144
  ds_read_b64_tr_b16 v[82:83], v16 offset:6400
  ds_read_b64_tr_b16 v[84:85], v17 offset:6144
  ds_read_b64_tr_b16 v[86:87], v17 offset:6400
  s_waitcnt lgkmcnt(0)
  v_mfma_f32_16x16x32_bf16 v[88:91], v[96:99], v[56:59], 0
  v_mfma_f32_16x16x32_bf16 v[92:95], v[96:99], v[60:63], 0
  v_mfma_f32_16x16x32_bf16 v[88:91], v[100:103], v[64:67], v[88:91]
  v_mfma_f32_16x16x32_bf16 v[92:95], v[100:103], v[68:71], v[92:95]
  v_mfma_f32_16x16x32_bf16 v[88:91], v[104:107], v[72:75], v[88:91]
  v_mfma_f32_16x16x32_bf16 v[92:95], v[104:107], v[76:79], v[92:95]
  v_mfma_f32_16x16x32_bf16 v[88:91], v[108:111], v[80:83], v[88:91]
  v_mfma_f32_16x16x32_bf16 v[92:95], v[108:111], v[84:87], v[92:95]
  s_branch L_lw22
L_lw21:
  s_sleep 1
L_lw22:
  ds_read_b32 v37, v2 offset:0
  s_waitcnt lgkmcnt(0)
  v_cmp_gt_i32 vcc, 50, v37
  s_cbranch_vccnz L_lw21
  ds_read_b64_tr_b16 v[56:57], v16 offset:8192
  ds_read_b64_tr_b16 v[58:59], v16 offset:8448
  ds_read_b64_tr_b16 v[60:61], v17 offset:8192
  ds_read_b64_tr_b16 v[62:63], v17 offset:8448
  ds_read_b64_tr_b16 v[64:65], v16 offset:10240
  ds_read_b64_tr_b16 v[66:67], v16 offset:10496
  ds_read_b64_tr_b16 v[68:69], v17 offset:10240
  ds_read_b64_tr_b16 v[70:71], v17 offset:10496
  ds_read_b64_tr_b16 v[72:73], v16 offset:12288
  ds_read_b64_tr_b16 v[74:75], v16 offset:12544
  ds_read_b64_tr_b16 v[76:77], v17 offset:12288
  ds_read_b64_tr_b16 v[78:79], v17 offset:12544
  ds_read_b64_tr_b16 v[80:81], v16 offset:14336
  ds_read_b64_tr_b16 v[82:83], v16 offset:14592
  ds_read_b64_tr_b16 v[84:85], v17 offset:14336
  ds_read_b64_tr_b16 v[86:87], v17 offset:14592
  s_waitcnt lgkmcnt(0)
  v_mfma_f32_16x16x32_bf16 v[88:91], v[112:115], v[56:59], v[88:91]
  v_mfma_f32_16x16x32_bf16 v[92:95], v[112:115], v[60:63], v[92:95]
  v_mfma_f32_16x16x32_bf16 v[88:91], v[116:119], v[64:67], v[88:91]
  v_mfma_f32_16x16x32_bf16 v[92:95], v[116:119], v[68:71], v[92:95]
  v_mfma_f32_16x16x32_bf16 v[88:91], v[120:123], v[72:75], v[88:91]
  v_mfma_f32_16x16x32_bf16 v[92:95], v[120:123], v[76:79], v[92:95]
  v_mfma_f32_16x16x32_bf16 v[88:91], v[124:127], v[80:83], v[88:91]
  v_mfma_f32_16x16x32_bf16 v[92:95], v[124:127], v[84:87], v[92:95]
  s_mov_b64 exec, 0xffff
  s_nop 6
  v_mov_b32 v89, v8
  v_mov_b32 v90, v92
  v_mov_b32 v91, v8
  global_store_dwordx4 v20, v[88:91], s[28:29]
  global_store_dwordx4 v29, v[88:91], s[28:29] sc1
  s_mov_b64 exec, -1
L_M_h:
  s_branch L_lw24
L_lw23:
  s_sleep 1
L_lw24:
L_tc3:
  s_cbranch_execz L_tc7
  ds_read_b32 v37, v2 offset:0
  s_waitcnt lgkmcnt(0)
  v_cmp_gt_i32 vcc, 74, v37
  s_cbranch_vccnz L_lw23
  s_mov_b32 s36, 262144
  global_load_dwordx4 v[40:43], v21, s[28:29] sc1
  global_load_dwordx4 v[44:47], v21, s[28:29] offset:1792 sc1
  global_load_dwordx4 v[48:51], v32, s[28:29] sc1
  global_load_dwordx4 v[52:55], v32, s[28:29] offset:1792 sc1
  s_branch L_lw29
L_lw28:
  s_sleep 1
L_lw29:
  ds_read_b32 v37, v2 offset:0
  s_waitcnt lgkmcnt(0)
  v_cmp_gt_i32 vcc, 64, v37
  s_cbranch_vccnz L_lw28
  ds_read_b64_tr_b16 v[128:129], v16 offset:16384
  ds_read_b64_tr_b16 v[130:131], v16 offset:16640
  ds_read_b64_tr_b16 v[132:133], v17 offset:16384
  ds_read_b64_tr_b16 v[134:135], v17 offset:16640
  ds_read_b64_tr_b16 v[136:137], v16 offset:18432
  ds_read_b64_tr_b16 v[138:139], v16 offset:18688
  ds_read_b64_tr_b16 v[140:141], v17 offset:18432
  ds_read_b64_tr_b16 v[142:143], v17 offset:18688
  ds_read_b64_tr_b16 v[144:145], v16 offset:20480
  ds_read_b64_tr_b16 v[146:147], v16 offset:20736
  ds_read_b64_tr_b16 v[148:149], v17 offset:20480
  ds_read_b64_tr_b16 v[150:151], v17 offset:20736
  ds_read_b64_tr_b16 v[152:153], v16 offset:22528
  ds_read_b64_tr_b16 v[154:155], v16 offset:22784
  ds_read_b64_tr_b16 v[156:157], v17 offset:22528
  ds_read_b64_tr_b16 v[158:159], v17 offset:22784
  ds_read_b64_tr_b16 v[160:161], v16 offset:24576
  ds_read_b64_tr_b16 v[162:163], v16 offset:24832
  ds_read_b64_tr_b16 v[164:165], v17 offset:24576
  ds_read_b64_tr_b16 v[166:167], v17 offset:24832
  ds_read_b64_tr_b16 v[168:169], v16 offset:26624
  ds_read_b64_tr_b16 v[170:171], v16 offset:26880
  ds_read_b64_tr_b16 v[172:173], v17 offset:26624
  ds_read_b64_tr_b16 v[174:175], v17 offset:26880
  ds_read_b64_tr_b16 v[176:177], v16 offset:28672
  ds_read_b64_tr_b16 v[178:179], v16 offset:28928
  ds_read_b64_tr_b16 v[180:181], v17 offset:28672
  ds_read_b64_tr_b16 v[182:183], v17 offset:28928
  s_waitcnt lgkmcnt(0)
  s_branch L_gc27
L_gp25:
  s_cmp_eq_u32 s36, 262120
  s_cbranch_scc0 L_gd30
  v_add_u32 v21, 589824, v21
  v_add_u32 v32, 589824, v32
L_gd30:
  global_load_dwordx4 v[40:43], v21, s[28:29] sc1
  global_load_dwordx4 v[44:47], v21, s[28:29] offset:1792 sc1
  global_load_dwordx4 v[48:51], v32, s[28:29] sc1
  global_load_dwordx4 v[52:55], v32, s[28:29] offset:1792 sc1
  s_sub_u32 s36, s36, 1
  s_cbranch_scc1 L_gx26
L_gc27:
  s_waitcnt vmcnt(0)
  v_xor_b32 v35, v41, v8
  v_bitop3_b32 v35, v35, v43, v8 bitop3:0xf6
  v_bitop3_b32 v35, v35, v45, v8 bitop3:0xf6
  v_bitop3_b32 v35, v35, v47, v8 bitop3:0xf6
  v_bitop3_b32 v35, v35, v49, v8 bitop3:0xf6
  v_bitop3_b32 v35, v35, v51, v8 bitop3:0xf6
  v_bitop3_b32 v35, v35, v53, v8 bitop3:0xf6
  v_bitop3_b32 v35, v35, v55, v8 bitop3:0xf6
  v_cmpx_lt_u32 vcc, 0, v35
  s_cbranch_execnz L_gp25
L_gx26:
  s_mov_b64 exec, -1
  v_add_f32 v40, v40, v44
  v_add_f32 v42, v42, v46
  v_add_f32 v48, v48, v52
  v_add_f32 v50, v50, v54
  v_cvt_pk_bf16_f32 v24, v40, v42
  v_cvt_pk_bf16_f32 v25, v48, v50
  v_lshlrev_b32 v22, 16, v22
  v_lshlrev_b32 v23, 16, v23
  v_lshlrev_b32 v30, 16, v30
  v_lshlrev_b32 v31, 16, v31
  v_lshlrev_b32 v40, 16, v24
  v_and_b32 v41, v11, v24
  v_lshlrev_b32 v42, 16, v25
  v_and_b32 v43, v11, v25
  v_add_f32 v40, v40, v22
  v_add_f32 v41, v41, v23
  v_add_f32 v42, v42, v30
  v_add_f32 v43, v43, v31
  v_cvt_pk_bf16_f32 v24, v40, v41
  v_cvt_pk_bf16_f32 v25, v42, v43
  v_lshlrev_b32 v40, 16, v24
  v_and_b32 v41, v11, v24
  v_lshlrev_b32 v42, 16, v25
  v_and_b32 v43, v11, v25
  v_mov_b32 v30, 0xc0135761
  v_mov_b32 v31, 0xbdd2d3e8
  v_mul_f32 v44, v40, v40
  v_mul_f32 v45, v41, v41
  v_mul_f32 v46, v42, v42
  v_mul_f32 v47, v43, v43
  v_fma_f32 v44, v44, v31, v30
  v_fma_f32 v45, v45, v31, v30
  v_fma_f32 v46, v46, v31, v30
  v_fma_f32 v47, v47, v31, v30
  v_mul_f32 v44, v44, v40
  v_mul_f32 v45, v45, v41
  v_mul_f32 v46, v46, v42
  v_mul_f32 v47, v47, v43
  v_exp_f32 v44, v44
  v_exp_f32 v45, v45
  v_exp_f32 v46, v46
  v_exp_f32 v47, v47
  s_nop 0
  v_add_f32 v44, 1.0, v44
  v_add_f32 v45, 1.0, v45
  v_add_f32 v46, 1.0, v46
  v_add_f32 v47, 1.0, v47
  v_rcp_f32 v44, v44
  v_rcp_f32 v45, v45
  v_rcp_f32 v46, v46
  v_rcp_f32 v47, v47
  s_nop 0
  v_mul_f32 v40, v40, v44
  v_mul_f32 v41, v41, v45
  v_mul_f32 v42, v42, v46
  v_mul_f32 v43, v43, v47
  v_cvt_pk_bf16_f32 v24, v40, v41
  v_cvt_pk_bf16_f32 v25, v42, v43
  v_lshlrev_b32 v27, 2, v0
  ds_write_b32 v27, v24 offset:3840
  ds_write_b32 v33, v25 offset:3840
  ds_read_b128 v[96:99], v18 offset:3840
  ds_read_b128 v[100:103], v18 offset:3904
  ds_read_b128 v[104:107], v18 offset:3968
  ds_read_b128 v[108:111], v18 offset:4032
  ds_read_b128 v[112:115], v18 offset:4096
  ds_read_b128 v[116:119], v18 offset:4160
  ds_read_b128 v[120:123], v18 offset:4224
  s_waitcnt lgkmcnt(0)
  v_mfma_f32_16x16x32_bf16 v[88:91], v[96:99], v[128:131], 0
  v_mfma_f32_16x16x32_bf16 v[92:95], v[96:99], v[132:135], 0
  v_mfma_f32_16x16x32_bf16 v[88:91], v[100:103], v[136:139], v[88:91]
  v_mfma_f32_16x16x32_bf16 v[92:95], v[100:103], v[140:143], v[92:95]
  v_mfma_f32_16x16x32_bf16 v[88:91], v[104:107], v[144:147], v[88:91]
  v_mfma_f32_16x16x32_bf16 v[92:95], v[104:107], v[148:151], v[92:95]
  v_mfma_f32_16x16x32_bf16 v[88:91], v[108:111], v[152:155], v[88:91]
  v_mfma_f32_16x16x32_bf16 v[92:95], v[108:111], v[156:159], v[92:95]
  v_mfma_f32_16x16x32_bf16 v[88:91], v[112:115], v[160:163], v[88:91]
  v_mfma_f32_16x16x32_bf16 v[92:95], v[112:115], v[164:167], v[92:95]
  v_mfma_f32_16x16x32_bf16 v[88:91], v[116:119], v[168:171], v[88:91]
  v_mfma_f32_16x16x32_bf16 v[92:95], v[116:119], v[172:175], v[92:95]
  v_mfma_f32_16x16x32_bf16 v[88:91], v[120:123], v[176:179], v[88:91]
  v_mfma_f32_16x16x32_bf16 v[92:95], v[120:123], v[180:183], v[92:95]
  s_mov_b64 exec, 0xffff
  s_nop 6
  v_mov_b32 v89, v8
  v_mov_b32 v90, v92
  v_mov_b32 v91, v8
  ds_read_b32 v37, v2 offset:0
  s_waitcnt lgkmcnt(0)
  v_cmp_gt_i32 vcc, 80, v37
  s_cbranch_vccnz L_M_gs
  s_branch L_lw32
L_lw31:
  s_sleep 1
L_lw32:
  ds_read_b32 v37, v2 offset:264
  s_waitcnt lgkmcnt(0)
  v_cmp_gt_i32 vcc, 4, v37
  s_cbranch_vccnz L_lw31
L_M_gs:
  global_store_dwordx4 v28, v[88:91], s[28:29] sc1
  s_endpgm
L_F:
L_tc4:
  s_cbranch_execz L_tc8
  s_sub_u32 s44, s31, 12
  s_lshl_b32 s44, s44, 3
  s_add_u32 s44, s44, s30
  s_lshl_b32 s33, s44, 10
  s_add_u32 s33, s33, 262144
  v_add_u32 v12, s33, v10
  s_lshl_b32 s33, s44, 12
  s_add_u32 s33, s33, 327680
  v_add_u32 v13, s33, v10
  s_lshr_b32 s33, s44, 1
  s_and_b32 s34, s44, 1
  s_lshl_b32 s33, s33, 6
  s_lshl_b32 s40, s34, 4
  s_add_u32 s33, s33, s40
  v_and_b32 v14, 23, v0
  v_lshl_add_u32 v14, v14, 1, s33
  s_branch L_lw34
L_lw33:
  s_sleep 4
L_lw34:
  ds_read_b32 v37, v2 offset:264
  s_waitcnt lgkmcnt(0)
  v_cmp_gt_i32 vcc, 4, v37
  s_cbranch_vccnz L_lw33
  ds_read_u16 v16, v14 offset:768
  ds_read_b32 v9, v2 offset:512
  s_waitcnt lgkmcnt(0)
  global_load_ushort v18, v14, s[22:23]
  s_mov_b32 s40, 0x9E3779B1
  v_mul_lo_u32 v8, v9, s40
  v_add_u32 v8, 0x7F4A7C15, v8
  v_or_b32 v8, 0x80000000, v8
  global_load_dwordx4 v[24:27], v12, s[28:29] sc1
  global_load_dwordx4 v[44:47], v13, s[28:29] offset:0 sc1
  global_load_dwordx4 v[48:51], v13, s[28:29] offset:1024 sc1
  global_load_dwordx4 v[52:55], v13, s[28:29] offset:2048 sc1
  global_load_dwordx4 v[56:59], v13, s[28:29] offset:3072 sc1
  v_lshlrev_b32 v16, 16, v16
  s_mov_b32 s36, 262144
  s_mov_b32 s42, 0
L_sp:
  global_load_dwordx4 v[28:31], v12, s[28:29] sc1
  global_load_dwordx4 v[60:63], v13, s[28:29] offset:0 sc1
  global_load_dwordx4 v[64:67], v13, s[28:29] offset:1024 sc1
  global_load_dwordx4 v[68:71], v13, s[28:29] offset:2048 sc1
  global_load_dwordx4 v[72:75], v13, s[28:29] offset:3072 sc1
  s_waitcnt vmcnt(5)
  s_cmp_eq_u32 s42, 1
  s_cbranch_scc1 L_sg0
  v_xor_b32 v32, v25, v8
  v_bitop3_b32 v32, v32, v27, v8 bitop3:0xf6
  v_cmp_ne_u32 vcc, 0, v32
  s_cbranch_vccnz L_sn0
  v_lshlrev_b32 v18, 16, v18
  v_add_f32_dpp v24, v24, v24 row_ror:8 row_mask:0xf bank_mask:0xf
  v_add_f32_dpp v26, v26, v26 row_ror:8 row_mask:0xf bank_mask:0xf
  s_nop 1
  v_permlane16_swap_b32 v24, v26
  v_add_f32 v25, v24, v26
  v_add_f32 v24, v24, v26
  s_nop 1
  v_permlane32_swap_b32 v24, v25
  v_add_f32 v24, v24, v25
  v_cvt_pk_bf16_f32 v24, v24, v24
  v_lshlrev_b32 v24, 16, v24
  v_add_f32 v24, v24, v18
  v_cvt_pk_bf16_f32 v24, v24, v24
  v_lshlrev_b32 v24, 16, v24
  v_mul_f32 v33, 0xbfb8aa3b, v24
  v_exp_f32 v33, v33
  s_nop 0
  v_add_f32 v33, 1.0, v33
  v_rcp_f32 v33, v33
  s_nop 0
  v_mul_f32 v24, v24, v33
  v_cvt_pk_bf16_f32 v18, v24, v24
  v_lshlrev_b32 v18, 16, v18
  s_mov_b32 s42, 1
L_sg0:
  v_xor_b32 v32, v45, v8
  v_bitop3_b32 v32, v32, v47, v8 bitop3:0xf6
  v_bitop3_b32 v32, v32, v49, v8 bitop3:0xf6
  v_bitop3_b32 v32, v32, v51, v8 bitop3:0xf6
  v_bitop3_b32 v32, v32, v53, v8 bitop3:0xf6
  v_bitop3_b32 v32, v32, v55, v8 bitop3:0xf6
  v_bitop3_b32 v32, v32, v57, v8 bitop3:0xf6
  v_bitop3_b32 v32, v32, v59, v8 bitop3:0xf6
  v_add_f32 v40, v44, v48
  v_add_f32 v42, v46, v50
  v_add_f32 v41, v52, v56
  v_add_f32 v43, v54, v58
  v_cmp_ne_u32 vcc, 0, v32
  s_cbranch_vccz L_sd
L_sn0:
  global_load_dwordx4 v[24:27], v12, s[28:29] sc1
  global_load_dwordx4 v[44:47], v13, s[28:29] offset:0 sc1
  global_load_dwordx4 v[48:51], v13, s[28:29] offset:1024 sc1
  global_load_dwordx4 v[52:55], v13, s[28:29] offset:2048 sc1
  global_load_dwordx4 v[56:59], v13, s[28:29] offset:3072 sc1
  s_waitcnt vmcnt(5)
  s_cmp_eq_u32 s42, 1
  s_cbranch_scc1 L_sg1
  v_xor_b32 v32, v29, v8
  v_bitop3_b32 v32, v32, v31, v8 bitop3:0xf6
  v_cmp_ne_u32 vcc, 0, v32
  s_cbranch_vccnz L_sn1
  v_lshlrev_b32 v18, 16, v18
  v_add_f32_dpp v28, v28, v28 row_ror:8 row_mask:0xf bank_mask:0xf
  v_add_f32_dpp v30, v30, v30 row_ror:8 row_mask:0xf bank_mask:0xf
  s_nop 1
  v_permlane16_swap_b32 v28, v30
  v_add_f32 v29, v28, v30
  v_add_f32 v28, v28, v30
  s_nop 1
  v_permlane32_swap_b32 v28, v29
  v_add_f32 v28, v28, v29
  v_cvt_pk_bf16_f32 v28, v28, v28
  v_lshlrev_b32 v28, 16, v28
  v_add_f32 v28, v28, v18
  v_cvt_pk_bf16_f32 v28, v28, v28
  v_lshlrev_b32 v28, 16, v28
  v_mul_f32 v33, 0xbfb8aa3b, v28
  v_exp_f32 v33, v33
  s_nop 0
  v_add_f32 v33, 1.0, v33
  v_rcp_f32 v33, v33
  s_nop 0
  v_mul_f32 v28, v28, v33
  v_cvt_pk_bf16_f32 v18, v28, v28
  v_lshlrev_b32 v18, 16, v18
  s_mov_b32 s42, 1
L_sg1:
  v_xor_b32 v32, v61, v8
  v_bitop3_b32 v32, v32, v63, v8 bitop3:0xf6
  v_bitop3_b32 v32, v32, v65, v8 bitop3:0xf6
  v_bitop3_b32 v32, v32, v67, v8 bitop3:0xf6
  v_bitop3_b32 v32, v32, v69, v8 bitop3:0xf6
  v_bitop3_b32 v32, v32, v71, v8 bitop3:0xf6
  v_bitop3_b32 v32, v32, v73, v8 bitop3:0xf6
  v_bitop3_b32 v32, v32, v75, v8 bitop3:0xf6
  v_add_f32 v40, v60, v64
  v_add_f32 v42, v62, v66
  v_add_f32 v41, v68, v72
  v_add_f32 v43, v70, v74
  v_cmp_ne_u32 vcc, 0, v32
  s_cbranch_vccz L_sd
L_sn1:
  s_sub_u32 s36, s36, 1
  s_cbranch_scc0 L_sp
L_sd:
  v_add_f32 v40, v40, v41
  v_add_f32 v42, v42, v43
  s_nop 0
  v_add_f32_dpp v40, v40, v40 row_ror:8 row_mask:0xf bank_mask:0xf
  v_add_f32_dpp v42, v42, v42 row_ror:8 row_mask:0xf bank_mask:0xf
  s_nop 1
  v_permlane16_swap_b32 v40, v42
  v_add_f32 v41, v40, v42
  v_add_f32 v40, v40, v42
  s_nop 1
  v_permlane32_swap_b32 v40, v41
  v_add_f32 v40, v40, v41
  v_cvt_pk_bf16_f32 v34, v40, v40
  v_lshlrev_b32 v34, 16, v34
  v_mul_f32 v34, v34, v18
  v_cvt_pk_bf16_f32 v34, v34, v34
  v_lshlrev_b32 v34, 16, v34
  v_add_f32 v34, v34, v16
  v_cvt_pk_bf16_f32 v34, v34, v34
  s_mov_b64 exec, 0x00ff00ff
  global_store_short v14, v34, s[24:25]
  s_cmp_eq_u32 s44, 0
  s_cbranch_scc0 L_F_end
  s_mov_b64 exec, 1
  global_store_dword v2, v8, s[28:29]
L_F_end:
  s_endpgm
L_C:
  s_lshl_b32 s34, s30, 15
  s_lshl_b32 s40, s31, 9
  s_add_u32 s34, s34, s40
  s_lshl_b32 s40, s39, 7
  s_add_u32 s34, s34, s40
  s_add_u32 s34, s34, 1048576
  v_lshlrev_b32 v21, 13, v4
  v_lshl_add_u32 v21, v5, 3, v21
  v_add_u32 v21, s34, v21
  s_lshl_b32 s34, s30, 10
  s_lshl_b32 s40, s31, 4
  s_add_u32 s34, s34, s40
  s_add_u32 s34, s34, 163840
  v_lshl_add_u32 v20, v4, 8, s34
  v_lshlrev_b32 v27, 4, v4
  s_lshl_b32 s34, s30, 13
  s_lshl_b32 s40, s39, 11
  s_add_u32 s34, s34, s40
L_tc5:
  s_cbranch_execz L_tret
  s_add_u32 s34, s34, 4096
  v_add_u32 v24, s34, v10
  v_mul_u32_u24 v28, 320, v6
  v_add_u32 v28, v28, v27
  v_mul_u32_u24 v26, 576, v6
  v_add_u32 v26, v26, v27
  s_mul_i32 s34, s39, 320
  v_and_b32 v29, 1, v4
  v_lshl_add_u32 v29, v29, 7, s34
  v_and_b32 v30, 32, v0
  v_add_u32 v29, v29, v30
  v_lshl_add_u32 v29, v5, 1, v29
  v_mov_b32 v25, 0x0c0c0400
  v_mov_b32 v23, 0x05040100
  v_mov_b32 v22, 0xffffff00
  v_lshrrev_b32 v30, 1, v5
  v_mul_u32_u24 v30, 1056, v30
  v_and_b32 v31, 1, v0
  v_lshl_add_u32 v30, v31, 9, v30
  v_xor_b32 v31, v4, v31
  v_lshl_add_u32 v30, v31, 4, v30
  s_mul_i32 s34, s39, 16896
  s_add_u32 s34, s34, 6656
  v_add_u32 v30, s34, v30
  v_mul_u32_u24 v31, 576, v4
  v_lshl_add_u32 v31, v5, 2, v31
  s_lshl_b32 s34, s39, 7
  v_add_u32 v31, s34, v31
  v_lshlrev_b32 v32, 5, v4
  s_lshl_b32 s34, s39, 3
  v_add_u32 v33, s34, v32
  s_lshl_b32 s43, s39, 4
  s_add_u32 s43, s43, 18
  v_mul_u32_u24 v34, 2176, v4
  v_lshl_add_u32 v34, v6, 8, v34
  v_lshl_add_u32 v34, v7, 3, v34
  s_lshl_b32 s34, s39, 1
  v_xor_b32 v35, s34, v6
  v_lshl_add_u32 v34, v35, 5, v34
  v_add_u32 v34, 74240, v34
  v_xor_b32 v35, 32, v34
  s_cmp_eq_u32 s39, 1
  s_cselect_b32 s45, 46, 44
  s_branch L_lw36
L_lw35:
  s_sleep 2
L_lw36:
  ds_read_b32 v37, v2 offset:0
  ds_read_b32 v9, v2 offset:512
  s_waitcnt lgkmcnt(0)
  v_cmp_gt_i32 vcc, s45, v37
  s_cbranch_vccnz L_lw35
  global_load_dwordx4 v[40:43], v24, s[28:29] offset:0 sc1
  global_load_dwordx4 v[44:47], v24, s[28:29] offset:1024 sc1
  s_mov_b32 s40, 0x9E3779B1
  v_mul_lo_u32 v8, v9, s40
  v_add_u32 v8, 0x7F4A7C15, v8
  v_or_b32 v8, 0x80000000, v8
  v_xor_b32 v38, s41, v8
  s_mov_b32 s36, 262144
  s_add_u32 s45, s45, 8
  s_branch L_lw38
L_lw37:
  s_sleep 1
L_lw38:
  ds_read_b32 v37, v2 offset:0
  s_waitcnt lgkmcnt(0)
  v_cmp_gt_i32 vcc, s45, v37
  s_cbranch_vccnz L_lw37
  global_load_dwordx4 v[48:51], v24, s[28:29] offset:0 sc1
  global_load_dwordx4 v[52:55], v24, s[28:29] offset:1024 sc1
  s_branch L_lw40
L_lw39:
  s_sleep 1
L_lw40:
  ds_read_b32 v37, v2 offset:0
  s_waitcnt lgkmcnt(0)
  v_cmp_gt_i32 vcc, s43, v37
  s_cbranch_vccnz L_lw39
  ds_read_b128 v[64:67], v30 offset:0
  ds_read_b128 v[68:71], v30 offset:64
  ds_read_b128 v[72:75], v30 offset:128
  ds_read_b128 v[76:79], v30 offset:192
  ds_read_b128 v[80:83], v30 offset:256
  ds_read_b128 v[84:87], v30 offset:320
  ds_read_b128 v[88:91], v30 offset:384
  ds_read_b128 v[92:95], v30 offset:448
  ds_read_b128 v[96:99], v30 offset:8448
  ds_read_b128 v[100:103], v30 offset:8512
  ds_read_b128 v[104:107], v30 offset:8576
  ds_read_b128 v[108:111], v30 offset:8640
  ds_read_b128 v[112:115], v30 offset:8704
  ds_read_b128 v[116:119], v30 offset:8768
  ds_read_b128 v[120:123], v30 offset:8832
  ds_read_b128 v[124:127], v30 offset:8896
  s_waitcnt lgkmcnt(0)
  s_branch L_C_qc
L_C_ql:
  global_load_dwordx4 v[48:51], v24, s[28:29] offset:0 sc1
  global_load_dwordx4 v[52:55], v24, s[28:29] offset:1024 sc1
L_C_qc:
  s_waitcnt vmcnt(2)
  v_perm_b32 v56, v41, v40, v25
  v_perm_b32 v57, v43, v42, v25
  v_perm_b32 v58, v45, v44, v25
  v_perm_b32 v59, v47, v46, v25
  v_perm_b32 v56, v57, v56, v23
  v_perm_b32 v58, v59, v58, v23
  v_xor_b32 v56, v56, v38
  v_bitop3_b32 v56, v56, v58, v38 bitop3:0xf6
  v_and_b32 v40, v22, v40
  v_and_b32 v41, v22, v41
  v_and_b32 v42, v22, v42
  v_and_b32 v43, v22, v43
  v_and_b32 v44, v22, v44
  v_and_b32 v45, v22, v45
  v_and_b32 v46, v22, v46
  v_and_b32 v47, v22, v47
  v_add_f32 v60, v40, v44
  v_add_f32 v61, v41, v45
  v_add_f32 v62, v42, v46
  v_add_f32 v63, v43, v47
  v_cmp_lt_u32 vcc, 7, v56
  s_cbranch_vccz L_C_qok
  global_load_dwordx4 v[40:43], v24, s[28:29] offset:0 sc1
  global_load_dwordx4 v[44:47], v24, s[28:29] offset:1024 sc1
  s_waitcnt vmcnt(2)
  v_perm_b32 v56, v49, v48, v25
  v_perm_b32 v57, v51, v50, v25
  v_perm_b32 v58, v53, v52, v25
  v_perm_b32 v59, v55, v54, v25
  v_perm_b32 v56, v57, v56, v23
  v_perm_b32 v58, v59, v58, v23
  v_xor_b32 v56, v56, v38
  v_bitop3_b32 v56, v56, v58, v38 bitop3:0xf6
  v_and_b32 v48, v22, v48
  v_and_b32 v49, v22, v49
  v_and_b32 v50, v22, v50
  v_and_b32 v51, v22, v51
  v_and_b32 v52, v22, v52
  v_and_b32 v53, v22, v53
  v_and_b32 v54, v22, v54
  v_and_b32 v55, v22, v55
  v_add_f32 v60, v48, v52
  v_add_f32 v61, v49, v53
  v_add_f32 v62, v50, v54
  v_add_f32 v63, v51, v55
  v_cmp_lt_u32 vcc, 7, v56
  s_cbranch_vccz L_C_qok
  s_sub_u32 s36, s36, 1
  s_cbranch_scc1 L_C_qok
  s_cmp_eq_u32 s36, 262120
  s_cbranch_scc0 L_C_ql
  v_add_u32 v24, 589824, v24
  s_branch L_C_ql
L_C_qok:
  v_permlane32_swap_b32 v60, v61
  v_permlane32_swap_b32 v62, v63
  v_cmp_ne_u32 vcc, 0, v56
  v_add_f32 v60, v60, v61
  v_add_f32 v62, v62, v63
  v_cvt_pk_bf16_f32 v57, v60, v62
  ds_write_b16 v29, v57 offset:2816
  ds_write_b16_d16_hi v29, v57 offset:2880
  s_cmp_eq_u64 vcc, 0
  s_cselect_b32 s35, 1, 0x101
  v_mov_b32 v58, s35
  s_mov_b64 exec, 1
  ds_add_u32 v2, v58 offset:256
  s_mov_b64 exec, -1
  s_branch L_lw42
L_lw41:
  s_sleep 1
L_lw42:
  ds_read_b32 v37, v2 offset:256
  ds_read_b128 v[128:131], v28 offset:2816
  ds_read_b128 v[132:135], v28 offset:2880
  ds_read_b128 v[136:139], v28 offset:2944
  ds_read_b128 v[140:143], v28 offset:3008
  s_waitcnt lgkmcnt(0)
  v_and_b32 v39, 255, v37
  v_cmp_gt_u32 vcc, 4, v39
  s_cbranch_vccnz L_lw41
  v_mfma_f32_16x16x32_bf16 v[144:147], v[128:131], v[64:67], 0
L_tc6:
  s_cbranch_execz L_tret
  v_mfma_f32_16x16x32_bf16 v[148:151], v[128:131], v[80:83], 0
  v_mfma_f32_16x16x32_bf16 v[152:155], v[128:131], v[96:99], 0
  v_mfma_f32_16x16x32_bf16 v[156:159], v[128:131], v[112:115], 0
  v_mfma_f32_16x16x32_bf16 v[144:147], v[132:135], v[68:71], v[144:147]
  v_mfma_f32_16x16x32_bf16 v[148:151], v[132:135], v[84:87], v[148:151]
  v_mfma_f32_16x16x32_bf16 v[152:155], v[132:135], v[100:103], v[152:155]
  v_mfma_f32_16x16x32_bf16 v[156:159], v[132:135], v[116:119], v[156:159]
  v_mfma_f32_16x16x32_bf16 v[144:147], v[136:139], v[72:75], v[144:147]
  v_mfma_f32_16x16x32_bf16 v[148:151], v[136:139], v[88:91], v[148:151]
  v_mfma_f32_16x16x32_bf16 v[152:155], v[136:139], v[104:107], v[152:155]
  v_mfma_f32_16x16x32_bf16 v[156:159], v[136:139], v[120:123], v[156:159]
  v_mfma_f32_16x16x32_bf16 v[144:147], v[140:143], v[76:79], v[144:147]
  v_mfma_f32_16x16x32_bf16 v[148:151], v[140:143], v[92:95], v[148:151]
  v_mfma_f32_16x16x32_bf16 v[152:155], v[140:143], v[108:111], v[152:155]
  v_mfma_f32_16x16x32_bf16 v[156:159], v[140:143], v[124:127], v[156:159]
  v_readfirstlane_b32 s37, v37
  v_mov_b32 v57, 0x3db504f3
  s_nop 4
  v_cvt_pk_bf16_f32 v58, v144, v148
  v_cvt_pk_bf16_f32 v59, v152, v156
  v_lshlrev_b32 v144, 16, v58
  v_and_b32 v148, v11, v58
  v_lshlrev_b32 v152, 16, v59
  v_and_b32 v156, v11, v59
  v_mul_f32 v144, v144, v57
  v_mul_f32 v148, v148, v57
  v_mul_f32 v152, v152, v57
  v_mul_f32 v156, v156, v57
  v_cvt_pk_bf16_f32 v58, v144, v148
  v_cvt_pk_bf16_f32 v59, v152, v156
  v_mov_b32 v57, 0x3fb8aa3b
  v_lshlrev_b32 v144, 16, v58
  v_and_b32 v148, v11, v58
  v_lshlrev_b32 v152, 16, v59
  v_and_b32 v156, v11, v59
  v_max3_f32 v56, v144, v148, v152
  v_max_f32 v56, v56, v156
  s_nop 1
  v_max_f32_dpp v56, v56, v56 quad_perm:[1,0,3,2] row_mask:0xf bank_mask:0xf
  s_nop 1
  v_max_f32_dpp v56, v56, v56 quad_perm:[2,3,0,1] row_mask:0xf bank_mask:0xf
  s_nop 1
  v_max_f32_dpp v56, v56, v56 row_half_mirror row_mask:0xf bank_mask:0xf
  s_nop 1
  v_max_f32_dpp v56, v56, v56 row_mirror row_mask:0xf bank_mask:0xf
  v_mul_f32 v56, v56, v57
  v_fma_f32 v58, v144, v57, -v56
  v_fma_f32 v59, v148, v57, -v56
  v_fma_f32 v60, v152, v57, -v56
  v_fma_f32 v61, v156, v57, -v56
  v_exp_f32 v58, v58
  v_exp_f32 v59, v59
  v_exp_f32 v60, v60
  v_exp_f32 v61, v61
  v_cvt_pk_bf16_f32 v62, v58, v59
  v_cvt_pk_bf16_f32 v63, v60, v61
  v_add_f32 v57, v58, v59
  v_add_f32 v58, v60, v61
  ds_write_b32 v31, v62 offset:4096
  v_add_f32 v57, v57, v58
  ds_write_b32 v31, v63 offset:4160
  s_nop 0
  v_add_f32_dpp v57, v57, v57 quad_perm:[1,0,3,2] row_mask:0xf bank_mask:0xf
  s_nop 1
  v_add_f32_dpp v57, v57, v57 quad_perm:[2,3,0,1] row_mask:0xf bank_mask:0xf
  s_nop 1
  v_add_f32_dpp v57, v57, v57 row_half_mirror row_mask:0xf bank_mask:0xf
  s_nop 1
  v_add_f32_dpp v57, v57, v57 row_mirror row_mask:0xf bank_mask:0xf
  ds_write_b64 v33, v[56:57] offset:6400
  s_mov_b64 exec, 1
  ds_add_u32 v2, v36 offset:260
  s_mov_b64 exec, -1
  ds_read_b32 v116, v2 offset:0
  ds_read_b64_tr_b16 v[68:69], v34 offset:0
  ds_read_b64_tr_b16 v[70:71], v34 offset:1024
  ds_read_b64_tr_b16 v[72:73], v35 offset:0
  ds_read_b64_tr_b16 v[74:75], v35 offset:1024
  ds_read_b64_tr_b16 v[76:77], v34 offset:8704
  ds_read_b64_tr_b16 v[78:79], v34 offset:9728
  ds_read_b64_tr_b16 v[80:81], v35 offset:8704
  ds_read_b64_tr_b16 v[82:83], v35 offset:9728
  ds_read_b64_tr_b16 v[84:85], v34 offset:17408
  ds_read_b64_tr_b16 v[86:87], v34 offset:18432
  ds_read_b64_tr_b16 v[88:89], v35 offset:17408
  ds_read_b64_tr_b16 v[90:91], v35 offset:18432
  ds_read_b64_tr_b16 v[92:93], v34 offset:26112
  ds_read_b64_tr_b16 v[94:95], v34 offset:27136
  ds_read_b64_tr_b16 v[96:97], v35 offset:26112
  ds_read_b64_tr_b16 v[98:99], v35 offset:27136
  ds_read_b64_tr_b16 v[100:101], v34 offset:34816
  ds_read_b64_tr_b16 v[102:103], v34 offset:35840
  ds_read_b64_tr_b16 v[104:105], v35 offset:34816
  ds_read_b64_tr_b16 v[106:107], v35 offset:35840
  ds_read_b64_tr_b16 v[108:109], v34 offset:43520
  ds_read_b64_tr_b16 v[110:111], v34 offset:44544
  ds_read_b64_tr_b16 v[112:113], v35 offset:43520
  ds_read_b64_tr_b16 v[114:115], v35 offset:44544
  s_branch L_lw44
L_lw43:
  s_sleep 1
L_lw44:
  ds_read_b32 v37, v2 offset:260
  ds_read_b128 v[56:59], v32 offset:6400
  ds_read_b128 v[60:63], v32 offset:6416
  s_waitcnt lgkmcnt(0)
  v_cmp_gt_i32 vcc, 4, v37
  s_cbranch_vccnz L_lw43
  ds_read_b128 v[128:131], v26 offset:4096
  ds_read_b128 v[132:135], v26 offset:4160
  ds_read_b128 v[136:139], v26 offset:4224
  ds_read_b128 v[140:143], v26 offset:4288
  ds_read_b128 v[144:147], v26 offset:4352
  ds_read_b128 v[148:151], v26 offset:4416
  ds_read_b128 v[152:155], v26 offset:4480
  ds_read_b128 v[156:159], v26 offset:4544
  v_max3_f32 v64, v56, v58, v60
  v_max_f32 v64, v64, v62
  v_sub_f32 v56, v56, v64
  v_sub_f32 v58, v58, v64
  v_sub_f32 v60, v60, v64
  v_sub_f32 v62, v62, v64
  v_exp_f32 v56, v56
  v_exp_f32 v58, v58
  v_exp_f32 v60, v60
  v_exp_f32 v62, v62
  v_mov_b32 v65, v8
  s_cmp_eq_u32 s39, 0
  s_cbranch_scc0 L_C_noml
  v_mul_f32 v66, v56, v57
  v_fmac_f32 v66, v58, v59
  v_fmac_f32 v66, v60, v61
  v_fmac_f32 v66, v62, v63
  v_mov_b32 v67, v8
  s_mov_b32 exec_lo, 0x00010001
  s_mov_b32 exec_hi, 0x00010001
  s_cmp_eq_u32 s37, 4
  s_cbranch_scc0 L_C_mls
  global_store_dwordx4 v20, v[64:67], s[28:29]
L_C_mle:
  s_mov_b64 exec, -1
L_C_noml:
  v_cmp_gt_i32 vcc, 98, v116
  s_cbranch_vccz L_C_pv
  s_branch L_lw46
L_lw45:
  s_sleep 1
L_lw46:
  ds_read_b32 v37, v2 offset:0
  s_waitcnt lgkmcnt(0)
  v_cmp_gt_i32 vcc, 98, v37
  s_cbranch_vccnz L_lw45
  ds_read_b64_tr_b16 v[68:69], v34 offset:0
  ds_read_b64_tr_b16 v[70:71], v34 offset:1024
  ds_read_b64_tr_b16 v[72:73], v35 offset:0
  ds_read_b64_tr_b16 v[74:75], v35 offset:1024
  ds_read_b64_tr_b16 v[76:77], v34 offset:8704
  ds_read_b64_tr_b16 v[78:79], v34 offset:9728
  ds_read_b64_tr_b16 v[80:81], v35 offset:8704
  ds_read_b64_tr_b16 v[82:83], v35 offset:9728
  ds_read_b64_tr_b16 v[84:85], v34 offset:17408
  ds_read_b64_tr_b16 v[86:87], v34 offset:18432
  ds_read_b64_tr_b16 v[88:89], v35 offset:17408
  ds_read_b64_tr_b16 v[90:91], v35 offset:18432
  ds_read_b64_tr_b16 v[92:93], v34 offset:26112
L_tc7:
  s_cbranch_execz L_tret
  ds_read_b64_tr_b16 v[94:95], v34 offset:27136
  ds_read_b64_tr_b16 v[96:97], v35 offset:26112
  ds_read_b64_tr_b16 v[98:99], v35 offset:27136
  s_waitcnt lgkmcnt(0)
L_C_pv:
  s_waitcnt lgkmcnt(0)
  v_mfma_f32_16x16x32_bf16 v[160:163], v[128:131], v[68:71], 0
  v_mfma_f32_16x16x32_bf16 v[164:167], v[128:131], v[72:75], 0
  v_mfma_f32_16x16x32_bf16 v[160:163], v[132:135], v[76:79], v[160:163]
  v_mfma_f32_16x16x32_bf16 v[164:167], v[132:135], v[80:83], v[164:167]
  v_mfma_f32_16x16x32_bf16 v[168:171], v[136:139], v[84:87], 0
  v_mfma_f32_16x16x32_bf16 v[172:175], v[136:139], v[88:91], 0
  v_mfma_f32_16x16x32_bf16 v[168:171], v[140:143], v[92:95], v[168:171]
  v_mfma_f32_16x16x32_bf16 v[172:175], v[140:143], v[96:99], v[172:175]
  v_cmp_gt_i32 vcc, 114, v116
  s_cbranch_vccz L_C_pv2
  s_branch L_lw48
L_lw47:
  s_sleep 1
L_lw48:
  ds_read_b32 v37, v2 offset:0
  ds_read_b64_tr_b16 v[100:101], v34 offset:34816
  ds_read_b64_tr_b16 v[102:103], v34 offset:35840
  ds_read_b64_tr_b16 v[104:105], v35 offset:34816
  ds_read_b64_tr_b16 v[106:107], v35 offset:35840
  ds_read_b64_tr_b16 v[108:109], v34 offset:43520
  ds_read_b64_tr_b16 v[110:111], v34 offset:44544
  ds_read_b64_tr_b16 v[112:113], v35 offset:43520
  ds_read_b64_tr_b16 v[114:115], v35 offset:44544
  s_waitcnt lgkmcnt(0)
  v_cmp_gt_i32 vcc, 114, v37
  s_cbranch_vccnz L_lw47
L_C_pv2:
  v_mfma_f32_16x16x32_bf16 v[176:179], v[144:147], v[100:103], 0
  v_mfma_f32_16x16x32_bf16 v[180:183], v[144:147], v[104:107], 0
  v_mfma_f32_16x16x32_bf16 v[176:179], v[148:151], v[108:111], v[176:179]
  v_mfma_f32_16x16x32_bf16 v[180:183], v[148:151], v[112:115], v[180:183]
  v_and_b32 v122, 1, v0
  v_lshlrev_b32 v122, 4, v122
  v_lshrrev_b32 v122, v122, v8
  v_lshrrev_b32 v123, 8, v122
  v_mov_b32 v119, 0xff
  v_mul_f32 v120, v160, v56
  v_mul_f32 v121, v164, v56
  v_fmac_f32 v120, v168, v58
  v_fmac_f32 v121, v172, v58
  v_fmac_f32 v120, v176, v60
  v_fmac_f32 v121, v180, v60
L_lw49:
  ds_read_b32 v37, v2 offset:0
  ds_read_b64_tr_b16 v[84:85], v34 offset:52224
  ds_read_b64_tr_b16 v[86:87], v34 offset:53248
  ds_read_b64_tr_b16 v[88:89], v35 offset:52224
  ds_read_b64_tr_b16 v[90:91], v35 offset:53248
  ds_read_b64_tr_b16 v[92:93], v34 offset:60928
  ds_read_b64_tr_b16 v[94:95], v34 offset:61952
  ds_read_b64_tr_b16 v[96:97], v35 offset:60928
  ds_read_b64_tr_b16 v[98:99], v35 offset:61952
  s_waitcnt lgkmcnt(0)
  v_cmp_gt_i32 vcc, 130, v37
  s_cbranch_vccnz L_lw49
  v_mfma_f32_16x16x32_bf16 v[184:187], v[152:155], v[84:87], 0
  v_mfma_f32_16x16x32_bf16 v[188:191], v[152:155], v[88:91], 0
  v_mfma_f32_16x16x32_bf16 v[184:187], v[156:159], v[92:95], v[184:187]
  v_mfma_f32_16x16x32_bf16 v[188:191], v[156:159], v[96:99], v[188:191]
  s_cmp_eq_u32 s37, 4
  s_nop 5
  v_fmac_f32 v120, v184, v62
  v_fmac_f32 v121, v188, v62
  v_bfi_b32 v120, v119, v122, v120
  v_bfi_b32 v121, v119, v123, v121
  s_cbranch_scc0 L_C_os
  global_store_dwordx2 v21, v[120:121], s[28:29]
L_C_oe:
  s_mov_b64 exec, 1
  ds_add_u32 v2, v36 offset:264
L_end:
  s_endpgm
L_C_os:
  global_store_dwordx2 v21, v[120:121], s[28:29] sc1
  s_branch L_C_oe
L_C_mls:
  global_store_dwordx4 v20, v[64:67], s[28:29] sc1
  s_branch L_C_mle
L_O:
  s_lshr_b32 s33, s46, 2
  s_and_b32 s32, s46, 3
  s_lshl_b32 s34, s30, 15
  s_lshl_b32 s40, s33, 13
  s_add_u32 s34, s34, s40
  s_lshl_b32 s40, s39, 7
  s_add_u32 s34, s34, s40
  s_add_u32 s34, s34, 1052672
  v_lshrrev_b32 v18, 3, v0
  v_lshlrev_b32 v16, 9, v18
  v_and_b32 v17, 7, v0
  v_lshl_add_u32 v16, v17, 4, v16
  v_add_u32 v16, s34, v16
  v_lshlrev_b32 v18, 3, v18
  s_lshl_b32 s34, s32, 15
  s_lshl_b32 s40, s39, 13
  s_add_u32 s34, s34, s40
  s_lshl_b32 s40, s30, 9
  s_add_u32 s34, s34, s40
  s_lshl_b32 s40, s33, 7
  s_add_u32 s34, s34, s40
  s_add_u32 s34, s34, 327680
  v_lshrrev_b32 v22, 3, v5
  v_lshlrev_b32 v22, 12, v22
  v_and_b32 v17, 7, v0
  v_lshl_add_u32 v22, v17, 4, v22
  v_add_u32 v22, s34, v22
  s_lshl_b32 s34, s39, 6
  v_lshl_add_u32 v17, v17, 3, s34
  v_lshl_add_u32 v17, v4, 1, v17
  v_lshlrev_b32 v27, 4, v4
  v_mul_u32_u24 v34, 2176, v4
  v_lshl_add_u32 v34, v6, 8, v34
  v_lshl_add_u32 v34, v7, 3, v34
  s_lshl_b32 s34, s39, 1
  v_xor_b32 v35, s34, v6
  v_lshl_add_u32 v34, v35, 5, v34
  v_add_u32 v34, 72192, v34
  v_xor_b32 v35, 32, v34
  s_branch L_lw52
L_lw51:
  s_sleep 4
L_lw52:
  ds_read_b32 v37, v2 offset:0
  ds_read_b32 v9, v2 offset:512
  s_waitcnt lgkmcnt(0)
  v_cmp_gt_i32 vcc, 34, v37
  s_cbranch_vccnz L_lw51
  s_mov_b32 s40, 0x9E3779B1
  v_mul_lo_u32 v8, v9, s40
  v_add_u32 v8, 0x7F4A7C15, v8
  v_or_b32 v8, 0x80000000, v8
  v_and_b32 v59, 0xff, v8
  v_bfe_u32 v61, v8, 8, 8
  v_bfe_u32 v62, v8, 16, 8
  v_lshrrev_b32 v63, 24, v8
  v_mov_b32 v60, 0xff
  s_mov_b32 s36, 262144
  s_branch L_lw54
L_lw53:
  s_sleep 1
L_lw54:
  ds_read_b32 v37, v2 offset:0
  s_waitcnt lgkmcnt(0)
  v_cmp_gt_i32 vcc, 88, v37
  s_cbranch_vccnz L_lw53
L_og:
  global_load_dwordx4 v[72:75], v16, s[28:29] offset:-4096 sc1
  global_load_dwordx4 v[76:79], v16, s[28:29] offset:0 sc1
  ds_read_b32 v116, v2 offset:0
  ds_read_b64_tr_b16 v[128:129], v34 offset:0
  ds_read_b64_tr_b16 v[130:131], v34 offset:1024
  ds_read_b64_tr_b16 v[132:133], v35 offset:0
  ds_read_b64_tr_b16 v[134:135], v35 offset:1024
  ds_read_b64_tr_b16 v[136:137], v34 offset:8704
  ds_read_b64_tr_b16 v[138:139], v34 offset:9728
  ds_read_b64_tr_b16 v[140:141], v35 offset:8704
  ds_read_b64_tr_b16 v[142:143], v35 offset:9728
  ds_read_b64_tr_b16 v[144:145], v34 offset:17408
  ds_read_b64_tr_b16 v[146:147], v34 offset:18432
  ds_read_b64_tr_b16 v[148:149], v35 offset:17408
  ds_read_b64_tr_b16 v[150:151], v35 offset:18432
  ds_read_b64_tr_b16 v[152:153], v34 offset:26112
  ds_read_b64_tr_b16 v[154:155], v34 offset:27136
  ds_read_b64_tr_b16 v[156:157], v35 offset:26112
  ds_read_b64_tr_b16 v[158:159], v35 offset:27136
  s_sub_u32 s36, s36, 1
  s_cbranch_scc1 L_ogx
  s_waitcnt vmcnt(0)
  ds_read_b32 v37, v2 offset:268
  ds_read_b64 v[124:125], v18 offset:4608
  v_xor_b32 v96, v72, v59
  v_xor_b32 v97, v73, v61
L_tc8:
  s_cbranch_execz L_tret
  v_xor_b32 v98, v74, v62
  v_xor_b32 v99, v75, v63
  v_xor_b32 v100, v76, v59
  v_xor_b32 v101, v77, v61
  v_xor_b32 v102, v78, v62
  v_xor_b32 v103, v79, v63
  v_or3_b32 v39, v96, v97, v98
  v_or3_b32 v104, v99, v100, v101
  v_or3_b32 v39, v39, v102, v103
  v_bitop3_b32 v39, v39, v104, v60 bitop3:0xa8
  v_cmp_ne_u32 vcc, 0, v39
  s_cbranch_vccz L_ogx
  s_waitcnt lgkmcnt(0)
  v_cmp_gt_i32 vcc, 96, v116
  s_cbranch_vccnz L_og
  v_cmpx_ne_u32 vcc, 0, v39
L_og2:
  global_load_dwordx4 v[72:75], v16, s[28:29] offset:-4096 sc1
  global_load_dwordx4 v[76:79], v16, s[28:29] offset:0 sc1
  s_mov_b64 exec, -1
  ds_read_b32 v37, v2 offset:268
  ds_read_b64 v[124:125], v18 offset:4608
  s_sub_u32 s36, s36, 1
  s_cbranch_scc1 L_og2x
  s_waitcnt vmcnt(0)
  v_xor_b32 v96, v72, v59
  v_xor_b32 v97, v73, v61
  v_xor_b32 v98, v74, v62
  v_xor_b32 v99, v75, v63
  v_xor_b32 v100, v76, v59
  v_xor_b32 v101, v77, v61
  v_xor_b32 v102, v78, v62
  v_xor_b32 v103, v79, v63
  v_or3_b32 v39, v96, v97, v98
  v_or3_b32 v104, v99, v100, v101
  v_or3_b32 v39, v39, v102, v103
  v_bitop3_b32 v39, v39, v104, v60 bitop3:0xa8
  v_cmpx_ne_u32 vcc, 0, v39
  s_cbranch_execnz L_og2
L_og2x:
  s_mov_b64 exec, -1
L_ogx:
  s_waitcnt lgkmcnt(0)
  v_cmp_gt_i32 vcc, 1, v37
  s_cbranch_vccz L_O_wte
L_lw55:
  ds_read_b32 v37, v2 offset:268
  ds_read_b64 v[124:125], v18 offset:4608
  s_waitcnt lgkmcnt(0)
  v_cmp_gt_i32 vcc, 1, v37
  s_cbranch_vccnz L_lw55
L_O_wte:
  v_mul_f32 v40, v96, v124
  v_mul_f32 v41, v97, v124
  v_mul_f32 v42, v98, v124
  v_mul_f32 v43, v99, v124
  v_fmac_f32 v40, v100, v125
  v_fmac_f32 v41, v101, v125
  v_fmac_f32 v42, v102, v125
  v_fmac_f32 v43, v103, v125
L_O_red:
  v_add_f32_dpp v40, v40, v40 row_ror:8 row_mask:0xf bank_mask:0xf
  v_add_f32_dpp v41, v41, v41 row_ror:8 row_mask:0xf bank_mask:0xf
  v_add_f32_dpp v42, v42, v42 row_ror:8 row_mask:0xf bank_mask:0xf
  v_add_f32_dpp v43, v43, v43 row_ror:8 row_mask:0xf bank_mask:0xf
  v_permlane16_swap_b32 v40, v41
  s_nop 0
  v_permlane16_swap_b32 v42, v43
  v_add_f32 v40, v40, v41
  v_add_f32 v42, v42, v43
  s_nop 1
  v_permlane32_swap_b32 v40, v42
  v_add_f32 v40, v40, v42
  v_cvt_pk_bf16_f32 v40, v40, v40
  ds_write_b16 v17, v40 offset:4352
  s_mov_b64 exec, 1
  ds_add_u32 v2, v36 offset:264
  s_mov_b64 exec, -1
  v_cmp_gt_i32 vcc, 96, v116
  s_cbranch_vccz L_O_woe
L_lw57:
  ds_read_b32 v37, v2 offset:0
  ds_read_b64_tr_b16 v[128:129], v34 offset:0
  ds_read_b64_tr_b16 v[130:131], v34 offset:1024
  ds_read_b64_tr_b16 v[132:133], v35 offset:0
  ds_read_b64_tr_b16 v[134:135], v35 offset:1024
  ds_read_b64_tr_b16 v[136:137], v34 offset:8704
  ds_read_b64_tr_b16 v[138:139], v34 offset:9728
  ds_read_b64_tr_b16 v[140:141], v35 offset:8704
  ds_read_b64_tr_b16 v[142:143], v35 offset:9728
  ds_read_b64_tr_b16 v[144:145], v34 offset:17408
  ds_read_b64_tr_b16 v[146:147], v34 offset:18432
  ds_read_b64_tr_b16 v[148:149], v35 offset:17408
  ds_read_b64_tr_b16 v[150:151], v35 offset:18432
  ds_read_b64_tr_b16 v[152:153], v34 offset:26112
  ds_read_b64_tr_b16 v[154:155], v34 offset:27136
  ds_read_b64_tr_b16 v[156:157], v35 offset:26112
  ds_read_b64_tr_b16 v[158:159], v35 offset:27136
  s_waitcnt lgkmcnt(0)
  v_cmp_gt_i32 vcc, 96, v37
  s_cbranch_vccnz L_lw57
L_O_woe:
L_lw59:
  ds_read_b32 v37, v2 offset:264
  ds_read_b128 v[40:43], v27 offset:4352
  ds_read_b128 v[44:47], v27 offset:4416
  ds_read_b128 v[48:51], v27 offset:4480
  ds_read_b128 v[52:55], v27 offset:4544
  s_waitcnt lgkmcnt(0)
  v_cmp_gt_i32 vcc, 4, v37
  s_cbranch_vccnz L_lw59
  v_mfma_f32_16x16x32_bf16 v[88:91], v[40:43], v[128:131], 0
  v_mfma_f32_16x16x32_bf16 v[92:95], v[40:43], v[132:135], 0
  v_mfma_f32_16x16x32_bf16 v[88:91], v[44:47], v[136:139], v[88:91]
  v_mfma_f32_16x16x32_bf16 v[92:95], v[44:47], v[140:143], v[92:95]
  v_mfma_f32_16x16x32_bf16 v[88:91], v[48:51], v[144:147], v[88:91]
  v_mfma_f32_16x16x32_bf16 v[92:95], v[48:51], v[148:151], v[92:95]
  v_mfma_f32_16x16x32_bf16 v[88:91], v[52:55], v[152:155], v[88:91]
  v_mfma_f32_16x16x32_bf16 v[92:95], v[52:55], v[156:159], v[92:95]
  s_mov_b64 exec, 0xffff
  s_nop 6
  v_mov_b32 v89, v8
  v_mov_b32 v90, v92
  v_mov_b32 v91, v8
  global_store_dwordx4 v22, v[88:91], s[28:29] sc1
  s_endpgm
.section .rodata,"a"
.p2align 6
.amdhsa_kernel recurrent_scan__sliding_block_cached__mixer_channel_mlp__decode_kernel
  .amdhsa_next_free_vgpr 192
  .amdhsa_next_free_sgpr 100
  .amdhsa_accum_offset 192
  .amdhsa_group_segment_fixed_size 0
  .amdhsa_kernarg_size 104
  .amdhsa_user_sgpr_count 2
  .amdhsa_user_sgpr_kernarg_segment_ptr 1
  .amdhsa_system_sgpr_workgroup_id_x 1
.end_amdhsa_kernel
```
